```python
import torch

def _softmax(x, axis=-1):
    return torch.softmax(x, dim=axis)
def _gelu(x):
    return torch.nn.functional.gelu(x, approximate="tanh")
def _silu(x):
    return torch.nn.functional.silu(x)
def _sigmoid(x):
    return torch.sigmoid(x)
def _layernorm(x, axis=-1, eps=1e-5):
    m = x.mean(dim=axis, keepdim=True)
    v = x.var(dim=axis, keepdim=True, unbiased=False)
    return (x - m) / torch.sqrt(v + eps)
def _scatter_add(tgt, idx, src, axis=0):
    return tgt.clone().index_add_(axis, idx, src)
def _segment_sum(src, seg, n):
    out = torch.zeros((n,) + src.shape[1:], dtype=src.dtype)
    return out.index_add_(0, seg, src)
def _pad(x, pw):
    flat = tuple(v for pair in reversed(pw) for v in pair)
    return torch.nn.functional.pad(x, flat)

kernel_name = 'standalone__instancenorm__sampling'

def setup_inputs():

    _w = (lambda a: (lambda t: t.to(torch.bfloat16) if t.is_floating_point() else t)(torch.as_tensor(a)))
    B, C, H, W = 16, 640, 16, 32
    return {
        "x": _w(abs((lambda *s: torch.randn(*s, dtype=torch.bfloat16) * 0.05)(B, C, H, W))),
        "g": _w((lambda *s: torch.randn(*s, dtype=torch.bfloat16) * 0.05)(C) + 1.0),
        "b": _w((lambda *s: torch.randn(*s, dtype=torch.bfloat16) * 0.4)(C)),
    }

def reference(x, g, b):
    mu = x.mean(axis=(-2, -1), keepdims=True)
    var = ((x - mu) ** 2).mean(axis=(-2, -1), keepdims=True)
    xhat = (x - mu) / torch.sqrt(var + 1e-5)
    return xhat * g.reshape(1, -1, 1, 1) + b.reshape(1, -1, 1, 1)
```

```asm
; @launch grid=(256,1,1) block=(656,1,1) lds=0
.amdgcn_target "amdgcn-amd-amdhsa--gfx950"
.text
.globl standalone__instancenorm__sampling_kernel
.p2align 13
.fill 4096, 4, 0xbf810000
.p2align 8
.type standalone__instancenorm__sampling_kernel,@function
standalone__instancenorm__sampling_kernel:
    s_load_dwordx8 s[4:11], s[0:1], 0
    s_cmpk_ge_u32 s2, 256
    s_cbranch_scc1 L_end
    v_lshrrev_b32 v2, 4, v0
    s_and_b32 s13, s2, 7
    s_cselect_b32 s13, 0, 8
    s_mul_i32 s3, s2, 41
    v_cmp_gt_u32 vcc, s13, v2
    s_nor_b32 s12, s2, 7
    s_cbranch_vccnz L_end
    s_add_u32 s3, s3, s12
    v_and_b32 v1, 15, v0
    v_add_u32 v2, s3, v2
    v_lshlrev_b32 v1, 4, v1
    v_lshl_add_u32 v1, v2, 10, v1
    s_waitcnt lgkmcnt(0)
    global_load_dwordx4 v[4:7], v1, s[4:5] offset:0
    global_load_dwordx4 v[8:11], v1, s[4:5] offset:256
    global_load_dwordx4 v[12:15], v1, s[4:5] offset:512
    global_load_dwordx4 v[16:19], v1, s[4:5] offset:768
    s_lshr_b32 s12, s2, 4
    s_mulk_i32 s12, 640
    v_mov_b32 v20, 0
    v_subrev_u32 v3, s12, v2
    v_mov_b32 v21, 0
    v_lshlrev_b32 v3, 1, v3
    global_load_short_d16_hi v20, v3, s[6:7]
    global_load_short_d16_hi v21, v3, s[8:9]
    v_readfirstlane_b32 s17, v0
    s_mov_b32 s16, 0xffff0000
    s_cmpk_lt_u32 s17, 128
    v_mov_b32 v56, 0x39a7c5ac
    v_mov_b32 v57, 0
    s_waitcnt vmcnt(5)
    global_load_ushort v2, v3, s[6:7]
    v_mov_b32_dpp v58, v4 row_newbcast:0 row_mask:0xf bank_mask:0xf
    v_lshlrev_b32 v24, 16, v4
    v_and_b32 v25, s16, v4
    v_and_b32 v58, s16, v58
    v_lshlrev_b32 v26, 16, v5
    v_and_b32 v27, s16, v5
    v_lshlrev_b32 v28, 16, v6
    v_and_b32 v29, s16, v6
    v_lshlrev_b32 v30, 16, v7
    v_and_b32 v31, s16, v7
    v_pk_add_f32 v[24:25], v[24:25], v[58:59] op_sel_hi:[1,0] neg_lo:[0,1] neg_hi:[0,1]
    v_pk_add_f32 v[26:27], v[26:27], v[58:59] op_sel_hi:[1,0] neg_lo:[0,1] neg_hi:[0,1]
    v_pk_add_f32 v[28:29], v[28:29], v[58:59] op_sel_hi:[1,0] neg_lo:[0,1] neg_hi:[0,1]
    v_pk_add_f32 v[30:31], v[30:31], v[58:59] op_sel_hi:[1,0] neg_lo:[0,1] neg_hi:[0,1]
    v_pk_fma_f32 v[56:57], v[24:25], v[24:25], v[56:57]
    v_pk_add_f32 v[22:23], v[24:25], v[26:27]
    v_pk_fma_f32 v[56:57], v[26:27], v[26:27], v[56:57]
    v_pk_add_f32 v[22:23], v[22:23], v[28:29]
    v_pk_fma_f32 v[56:57], v[28:29], v[28:29], v[56:57]
    v_pk_add_f32 v[22:23], v[22:23], v[30:31]
    v_pk_fma_f32 v[56:57], v[30:31], v[30:31], v[56:57]
    s_waitcnt vmcnt(5)
    v_lshlrev_b32 v32, 16, v8
    v_and_b32 v33, s16, v8
    v_lshlrev_b32 v34, 16, v9
    v_and_b32 v35, s16, v9
    v_lshlrev_b32 v36, 16, v10
    v_and_b32 v37, s16, v10
    v_lshlrev_b32 v38, 16, v11
    v_and_b32 v39, s16, v11
    v_pk_add_f32 v[32:33], v[32:33], v[58:59] op_sel_hi:[1,0] neg_lo:[0,1] neg_hi:[0,1]
    v_pk_add_f32 v[34:35], v[34:35], v[58:59] op_sel_hi:[1,0] neg_lo:[0,1] neg_hi:[0,1]
    v_pk_add_f32 v[36:37], v[36:37], v[58:59] op_sel_hi:[1,0] neg_lo:[0,1] neg_hi:[0,1]
    v_pk_add_f32 v[38:39], v[38:39], v[58:59] op_sel_hi:[1,0] neg_lo:[0,1] neg_hi:[0,1]
    v_pk_add_f32 v[22:23], v[22:23], v[32:33]
    v_pk_fma_f32 v[56:57], v[32:33], v[32:33], v[56:57]
    v_pk_add_f32 v[22:23], v[22:23], v[34:35]
    v_pk_fma_f32 v[56:57], v[34:35], v[34:35], v[56:57]
    v_pk_add_f32 v[22:23], v[22:23], v[36:37]
    v_pk_fma_f32 v[56:57], v[36:37], v[36:37], v[56:57]
    v_pk_add_f32 v[22:23], v[22:23], v[38:39]
    v_pk_fma_f32 v[56:57], v[38:39], v[38:39], v[56:57]
    s_waitcnt vmcnt(4)
    v_lshlrev_b32 v40, 16, v12
    v_and_b32 v41, s16, v12
    v_lshlrev_b32 v42, 16, v13
    v_and_b32 v43, s16, v13
    v_lshlrev_b32 v44, 16, v14
    v_and_b32 v45, s16, v14
    v_lshlrev_b32 v46, 16, v15
    v_and_b32 v47, s16, v15
    v_pk_add_f32 v[40:41], v[40:41], v[58:59] op_sel_hi:[1,0] neg_lo:[0,1] neg_hi:[0,1]
    v_pk_add_f32 v[42:43], v[42:43], v[58:59] op_sel_hi:[1,0] neg_lo:[0,1] neg_hi:[0,1]
    v_pk_add_f32 v[44:45], v[44:45], v[58:59] op_sel_hi:[1,0] neg_lo:[0,1] neg_hi:[0,1]
    v_pk_add_f32 v[46:47], v[46:47], v[58:59] op_sel_hi:[1,0] neg_lo:[0,1] neg_hi:[0,1]
    v_pk_add_f32 v[22:23], v[22:23], v[40:41]
    v_pk_fma_f32 v[56:57], v[40:41], v[40:41], v[56:57]
    v_pk_add_f32 v[22:23], v[22:23], v[42:43]
    v_pk_fma_f32 v[56:57], v[42:43], v[42:43], v[56:57]
    v_pk_add_f32 v[22:23], v[22:23], v[44:45]
    v_pk_fma_f32 v[56:57], v[44:45], v[44:45], v[56:57]
    v_pk_add_f32 v[22:23], v[22:23], v[46:47]
    v_pk_fma_f32 v[56:57], v[46:47], v[46:47], v[56:57]
    s_waitcnt vmcnt(3)
    v_lshlrev_b32 v48, 16, v16
    v_and_b32 v49, s16, v16
    v_lshlrev_b32 v50, 16, v17
    v_and_b32 v51, s16, v17
    v_lshlrev_b32 v52, 16, v18
    v_and_b32 v53, s16, v18
    v_lshlrev_b32 v54, 16, v19
    v_and_b32 v55, s16, v19
    v_pk_add_f32 v[48:49], v[48:49], v[58:59] op_sel_hi:[1,0] neg_lo:[0,1] neg_hi:[0,1]
    v_pk_add_f32 v[50:51], v[50:51], v[58:59] op_sel_hi:[1,0] neg_lo:[0,1] neg_hi:[0,1]
    v_pk_add_f32 v[52:53], v[52:53], v[58:59] op_sel_hi:[1,0] neg_lo:[0,1] neg_hi:[0,1]
    v_pk_add_f32 v[54:55], v[54:55], v[58:59] op_sel_hi:[1,0] neg_lo:[0,1] neg_hi:[0,1]
    v_pk_add_f32 v[22:23], v[22:23], v[48:49]
    v_pk_fma_f32 v[56:57], v[48:49], v[48:49], v[56:57]
    v_pk_add_f32 v[22:23], v[22:23], v[50:51]
    v_pk_fma_f32 v[56:57], v[50:51], v[50:51], v[56:57]
    v_pk_add_f32 v[22:23], v[22:23], v[52:53]
    v_pk_fma_f32 v[56:57], v[52:53], v[52:53], v[56:57]
    v_pk_add_f32 v[22:23], v[22:23], v[54:55]
    v_pk_fma_f32 v[56:57], v[54:55], v[54:55], v[56:57]
    v_add_f32 v22, v22, v23
    v_add_f32 v56, v56, v57
    s_nop 0
    v_add_f32_dpp v22, v22, v22 row_ror:8 row_mask:0xf bank_mask:0xf
    v_add_f32_dpp v56, v56, v56 row_ror:8 row_mask:0xf bank_mask:0xf
    s_nop 0
    v_add_f32_dpp v22, v22, v22 row_ror:4 row_mask:0xf bank_mask:0xf
    v_add_f32_dpp v56, v56, v56 row_ror:4 row_mask:0xf bank_mask:0xf
    s_nop 0
    v_add_f32_dpp v22, v22, v22 row_ror:2 row_mask:0xf bank_mask:0xf
    v_add_f32_dpp v56, v56, v56 row_ror:2 row_mask:0xf bank_mask:0xf
    s_nop 0
    v_add_f32_dpp v22, v22, v22 row_ror:1 row_mask:0xf bank_mask:0xf
    v_add_f32_dpp v56, v56, v56 row_ror:1 row_mask:0xf bank_mask:0xf
    v_mul_f32 v23, 0xbb000000, v22
    v_fma_f32 v56, v23, v22, v56
    v_max_f32 v56, 0x3ba7c5ac, v56
    v_rsq_f32 v56, v56
    s_waitcnt vmcnt(1)
    v_mul_f32 v20, 0x41b504f3, v20
    v_mul_f32 v20, v20, v56
    v_fma_f32 v21, v23, v20, v21
    v_pk_fma_f32 v[24:25], v[24:25], v[20:21], v[20:21] op_sel:[0,0,1] op_sel_hi:[1,0,1]
    v_pk_fma_f32 v[26:27], v[26:27], v[20:21], v[20:21] op_sel:[0,0,1] op_sel_hi:[1,0,1]
    v_pk_fma_f32 v[28:29], v[28:29], v[20:21], v[20:21] op_sel:[0,0,1] op_sel_hi:[1,0,1]
    v_pk_fma_f32 v[30:31], v[30:31], v[20:21], v[20:21] op_sel:[0,0,1] op_sel_hi:[1,0,1]
    v_cvt_pk_bf16_f32 v4, v24, v25
    v_cvt_pk_bf16_f32 v5, v26, v27
    v_cvt_pk_bf16_f32 v6, v28, v29
    v_cvt_pk_bf16_f32 v7, v30, v31
    v_pk_fma_f32 v[32:33], v[32:33], v[20:21], v[20:21] op_sel:[0,0,1] op_sel_hi:[1,0,1]
    v_pk_fma_f32 v[34:35], v[34:35], v[20:21], v[20:21] op_sel:[0,0,1] op_sel_hi:[1,0,1]
    v_pk_fma_f32 v[36:37], v[36:37], v[20:21], v[20:21] op_sel:[0,0,1] op_sel_hi:[1,0,1]
    v_pk_fma_f32 v[38:39], v[38:39], v[20:21], v[20:21] op_sel:[0,0,1] op_sel_hi:[1,0,1]
    v_cvt_pk_bf16_f32 v8, v32, v33
    v_cvt_pk_bf16_f32 v9, v34, v35
    v_cvt_pk_bf16_f32 v10, v36, v37
    v_cvt_pk_bf16_f32 v11, v38, v39
    v_pk_fma_f32 v[40:41], v[40:41], v[20:21], v[20:21] op_sel:[0,0,1] op_sel_hi:[1,0,1]
    v_pk_fma_f32 v[42:43], v[42:43], v[20:21], v[20:21] op_sel:[0,0,1] op_sel_hi:[1,0,1]
    v_pk_fma_f32 v[44:45], v[44:45], v[20:21], v[20:21] op_sel:[0,0,1] op_sel_hi:[1,0,1]
    v_pk_fma_f32 v[46:47], v[46:47], v[20:21], v[20:21] op_sel:[0,0,1] op_sel_hi:[1,0,1]
    v_cvt_pk_bf16_f32 v12, v40, v41
    v_cvt_pk_bf16_f32 v13, v42, v43
    v_cvt_pk_bf16_f32 v14, v44, v45
    v_cvt_pk_bf16_f32 v15, v46, v47
    v_pk_fma_f32 v[48:49], v[48:49], v[20:21], v[20:21] op_sel:[0,0,1] op_sel_hi:[1,0,1]
    v_pk_fma_f32 v[50:51], v[50:51], v[20:21], v[20:21] op_sel:[0,0,1] op_sel_hi:[1,0,1]
    v_pk_fma_f32 v[52:53], v[52:53], v[20:21], v[20:21] op_sel:[0,0,1] op_sel_hi:[1,0,1]
    v_pk_fma_f32 v[54:55], v[54:55], v[20:21], v[20:21] op_sel:[0,0,1] op_sel_hi:[1,0,1]
    v_cvt_pk_bf16_f32 v16, v48, v49
    v_cvt_pk_bf16_f32 v17, v50, v51
    v_cvt_pk_bf16_f32 v18, v52, v53
    v_cvt_pk_bf16_f32 v19, v54, v55
    s_cbranch_scc1 L_x
    s_waitcnt vmcnt(0)
L_x:
    global_store_dwordx4 v1, v[4:7], s[10:11] offset:0 nt
    global_store_dwordx4 v1, v[8:11], s[10:11] offset:256 nt
    global_store_dwordx4 v1, v[12:15], s[10:11] offset:512 nt
    global_store_dwordx4 v1, v[16:19], s[10:11] offset:768 nt
L_end:
    s_endpgm
.section .rodata,"a"
.p2align 6
.amdhsa_kernel standalone__instancenorm__sampling_kernel
  .amdhsa_next_free_vgpr 60
  .amdhsa_next_free_sgpr 24
  .amdhsa_accum_offset 60
  .amdhsa_group_segment_fixed_size 0
  .amdhsa_kernarg_size 48
  .amdhsa_user_sgpr_count 2
  .amdhsa_user_sgpr_kernarg_segment_ptr 1
  .amdhsa_system_sgpr_workgroup_id_x 1
  .amdhsa_float_denorm_mode_32 3
.end_amdhsa_kernel
```
